```python
import torch

def _softmax(x, axis=-1):
    return torch.softmax(x, dim=axis)

def _gelu(x):
    return torch.nn.functional.gelu(x, approximate='tanh')

def _silu(x):
    return torch.nn.functional.silu(x)

def _sigmoid(x):
    return torch.sigmoid(x)

def _layernorm(x, axis=-1, eps=1e-05):
    m = x.mean(dim=axis, keepdim=True)
    v = x.var(dim=axis, keepdim=True, unbiased=False)
    return (x - m) / torch.sqrt(v + eps)

def _scatter_add(tgt, idx, src, axis=0):
    return tgt.clone().index_add_(axis, idx, src)

def _segment_sum(src, seg, n):
    out = torch.zeros((n,) + src.shape[1:], dtype=src.dtype)
    return out.index_add_(0, seg, src)

def _pad(x, pw):
    flat = tuple((v for pair in reversed(pw) for v in pair))
    return torch.nn.functional.pad(x, flat)
kernel_name = 'standalone__tree_speculative_verify_tree_attention_over_candidate_token_tree__sampling'

def setup_inputs():

    _w = lambda a: (lambda t: t.to(torch.bfloat16) if t.is_floating_point() else t)(torch.as_tensor(a))
    B, Hq, Hkv, T, C, D = (8, 32, 16, 1, 8192, 128)
    tree_mask = torch.zeros((B, T, T), dtype=float)
    for b in range(B):
        parent = torch.zeros(T, dtype=torch.int64)
        for i in range(1, T):
            parent[i] = int(torch.randint(0, i, (1,)).item())
        for i in range(T):
            j = i
            tree_mask[b, i, j] = 1.0
            while j > 0:
                j = parent[j]
                tree_mask[b, i, j] = 1.0
    return {'q': _w((lambda *s: torch.randn(*s, dtype=torch.bfloat16) * 0.8)(B, Hq, T, D)), 'k_cache': _w((lambda *s: torch.randn(*s, dtype=torch.bfloat16) * 0.8)(B, Hkv, C, D)), 'v_cache': _w((lambda *s: torch.randn(*s, dtype=torch.bfloat16) * 0.05)(B, Hkv, C, D)), 'k_tree': _w((lambda *s: torch.randn(*s, dtype=torch.bfloat16) * 0.8)(B, Hkv, T, D)), 'v_tree': _w((lambda *s: torch.randn(*s, dtype=torch.bfloat16) * 0.05)(B, Hkv, T, D)), 'tree_mask': _w(tree_mask)}

def reference(q, k_cache, v_cache, k_tree, v_tree, tree_mask):
    B, Hq, T, D = q.shape
    Hkv, C = (k_cache.shape[1], k_cache.shape[2])
    rep = Hq // Hkv
    kc = (lambda x, n, axis: torch.repeat_interleave(x, n, dim=axis))(k_cache, rep, axis=1)
    vc = (lambda x, n, axis: torch.repeat_interleave(x, n, dim=axis))(v_cache, rep, axis=1)
    kt = (lambda x, n, axis: torch.repeat_interleave(x, n, dim=axis))(k_tree, rep, axis=1)
    vt = (lambda x, n, axis: torch.repeat_interleave(x, n, dim=axis))(v_tree, rep, axis=1)
    k = torch.concatenate([kc, kt], axis=2)
    v = torch.concatenate([vc, vt], axis=2)
    scale = D ** (-0.5)
    scores = torch.einsum('bhqd,bhkd->bhqk', q, k) * scale
    ctx_mask = torch.ones((B, 1, T, C), dtype=scores.dtype)
    tm = tree_mask[:, None, :, :].clone()
    full_mask = torch.concatenate([ctx_mask, tm], axis=-1)
    scores = scores + (1.0 - full_mask) * -1000000000.0
    p = _softmax(scores, axis=-1)
    return torch.einsum('bhqk,bhkd->bhqd', p, v)
```

```asm
; @launch grid=(256,1,1) block=(256,1,1) lds=98304
.amdgcn_target "amdgcn-amd-amdhsa--gfx950"
.text
.globl standalone__tree_speculative_verify_tree_attention_over_candidate_token_tree__sampling_kernel
.p2align 8
.type standalone__tree_speculative_verify_tree_attention_over_candidate_token_tree__sampling_kernel,@function
standalone__tree_speculative_verify_tree_attention_over_candidate_token_tree__sampling_kernel:
  s_cmp_ge_u32 s2, 256
  s_cbranch_scc1 L_exit
  s_load_dwordx16 s[4:19], s[0:1], 0
  s_load_dwordx2 s[20:21], s[0:1], 64
  v_and_b32 v59, 63, v0
  v_lshrrev_b32 v3, 6, v0
  s_nop 0
  v_readfirstlane_b32 s3, v3
  s_lshr_b32 s22, s2, 1
  s_and_b32 s23, s2, 1
  v_lshrrev_b32 v60, 4, v59
  v_and_b32 v61, 15, v59
  v_lshlrev_b32 v2, 4, v59
  v_lshrrev_b32 v62, 2, v61
  v_lshlrev_b32 v62, 8, v62
  v_and_b32 v63, 3, v61
  v_lshlrev_b32 v63, 4, v63
  v_lshl_add_u32 v63, v60, 6, v63
  v_add_u32 v1, v62, v63
  v_lshrrev_b32 v62, 3, v61
  v_lshlrev_b32 v62, 8, v62
  v_add_u32 v3, v62, v63
  v_add_u32 v72, 0, v2
  v_add_u32 v73, 1024, v2
  v_add_u32 v74, 2048, v2
  v_add_u32 v75, 3072, v2
  v_add_u32 v16, 0, v1
  v_add_u32 v17, 1024, v1
  v_add_u32 v18, 2048, v1
  v_add_u32 v19, 3072, v1
  v_lshrrev_b32 v62, 3, v61
  v_lshl_add_u32 v62, v60, 1, v62
  v_lshlrev_b32 v62, 4, v62
  s_mul_i32 s36, s3, 8192
  v_add_u32 v58, s36, v62
  v_and_b32 v62, 1, v61
  v_cmp_eq_u32 vcc, 1, v62
  v_mov_b32 v62, 0xffff
  v_mov_b32 v63, 0xffff0000
  v_cndmask_b32 v62, v62, v63, vcc
  v_bfe_u32 v63, v61, 1, 2
  v_cmp_eq_u32 vcc, 0, v63
  s_nop 1
  v_cndmask_b32 v20, 0, v62, vcc
  v_cmp_eq_u32 vcc, 1, v63
  s_nop 1
  v_cndmask_b32 v21, 0, v62, vcc
  v_cmp_eq_u32 vcc, 2, v63
  s_nop 1
  v_cndmask_b32 v22, 0, v62, vcc
  v_cmp_eq_u32 vcc, 3, v63
  s_nop 1
  v_cndmask_b32 v23, 0, v62, vcc
  s_mov_b32 s34, 0x3e0293ee
  s_mov_b32 s35, 0xbe0293ee
  v_mov_b32 v55, 0xff800000
  v_mov_b32 v57, 0xff800000
  v_mov_b32 v64, 0
  v_mov_b32 v65, 0
  v_mov_b32 v66, 0
  v_mov_b32 v67, 0
  s_waitcnt lgkmcnt(0)
  s_lshl_b32 s36, s22, 9
  s_add_u32 s4, s4, s36
  s_addc_u32 s5, s5, 0
  global_load_dwordx4 v[4:7], v3, s[4:5] offset:0
  s_lshl_b32 s36, s22, 21
  s_mul_i32 s37, s23, 32768
  s_add_u32 s36, s36, s37
  s_mul_i32 s37, s3, 4096
  s_add_u32 s36, s36, s37
  s_add_u32 s24, s6, s36
  s_addc_u32 s25, s7, 0
  s_and_b32 s25, s25, 0xffff
  s_mov_b32 s26, 0x200000
  s_mul_i32 s27, s23, 32768
  s_sub_u32 s26, s26, s27
  s_sub_u32 s26, s26, s37
  s_mov_b32 s27, 0x20000
  s_add_u32 s28, s8, s36
  s_addc_u32 s29, s9, 0
  s_and_b32 s29, s29, 0xffff
  s_mov_b32 s30, s26
  s_mov_b32 s31, 0x20000
  s_or_b32 s38, s23, s3
  s_cmp_lg_u32 s38, 0
  s_cbranch_scc1 L_notree_issue
  s_lshl_b32 s36, s22, 8
  s_add_u32 s10, s10, s36
  s_addc_u32 s11, s11, 0
  s_add_u32 s12, s12, s36
  s_addc_u32 s13, s13, 0
  v_and_b32 v63, 3, v61
  v_lshlrev_b32 v63, 4, v63
  v_lshl_add_u32 v62, v60, 6, v63
  global_load_dwordx4 v[40:43], v62, s[10:11]
  v_and_b32 v63, 7, v61
  v_lshlrev_b32 v63, 1, v63
  v_lshl_add_u32 v63, v60, 6, v63
  global_load_ushort v64, v63, s[12:13] offset:0
  global_load_ushort v65, v63, s[12:13] offset:16
  global_load_ushort v66, v63, s[12:13] offset:32
  global_load_ushort v67, v63, s[12:13] offset:48
  s_lshr_b32 s36, s22, 4
  s_lshl_b32 s37, s36, 1
  s_and_b32 s37, s37, 0xfffffffc
  s_load_dword s39, s[14:15], s37
L_notree_issue:
  s_mov_b32 s70, 0
  s_bfe_u32 s68, s70, 0x10000
  s_lshl_b32 s68, s68, 14
  s_bfe_u32 s71, s70, 0x50001
  s_lshl_b32 s71, s71, 16
  s_or_b32 s68, s68, s71
  s_add_u32 s70, s70, 1
  buffer_load_dwordx4 v[76:79], v1, s[24:27], s68 offen offset:0 nt
  buffer_load_dwordx4 v[80:83], v1, s[24:27], s68 offen offset:1024 nt
  buffer_load_dwordx4 v[84:87], v1, s[24:27], s68 offen offset:2048 nt
  buffer_load_dwordx4 v[88:91], v1, s[24:27], s68 offen offset:3072 nt
  s_bfe_u32 s68, s70, 0x10000
  s_lshl_b32 s68, s68, 14
  s_bfe_u32 s71, s70, 0x50001
  s_lshl_b32 s71, s71, 16
  s_or_b32 s68, s68, s71
  s_add_u32 s70, s70, 1
  buffer_load_dwordx4 v[92:95], v1, s[24:27], s68 offen offset:0 nt
  buffer_load_dwordx4 v[96:99], v1, s[24:27], s68 offen offset:1024 nt
  buffer_load_dwordx4 v[100:103], v1, s[24:27], s68 offen offset:2048 nt
  buffer_load_dwordx4 v[104:107], v1, s[24:27], s68 offen offset:3072 nt
  s_cmp_lg_u32 s38, 0
  s_cbranch_scc1 L_notree
  s_waitcnt lgkmcnt(0)
  s_and_b32 s36, s36, 1
  s_lshl_b32 s36, s36, 4
  s_lshr_b32 s39, s39, s36
  s_lshl_b32 s39, s39, 16
  s_waitcnt vmcnt(8)
  v_mov_b32 v60, s34
  v_mfma_f32_16x16x32_bf16 v[36:39], v[40:43], v[4:7], 0
  s_nop 7
  v_mul_f32_dpp v28, v36, v60 quad_perm:[0,0,0,0] row_mask:0xf bank_mask:0xf
  v_fmac_f32_dpp v28, v37, v60 quad_perm:[1,1,1,1] row_mask:0xf bank_mask:0xf
  v_fmac_f32_dpp v28, v38, v60 quad_perm:[2,2,2,2] row_mask:0xf bank_mask:0xf
  v_fmac_f32_dpp v28, v39, v60 quad_perm:[3,3,3,3] row_mask:0xf bank_mask:0xf
  v_sub_f32 v62, 1.0, s39
  v_mul_f32 v62, 0xceabfb8f, v62
  v_add_f32 v57, v28, v62
  v_lshlrev_b32 v64, 16, v64
  v_lshlrev_b32 v65, 16, v65
  v_lshlrev_b32 v66, 16, v66
  v_lshlrev_b32 v67, 16, v67
L_notree:
  v_mov_b32 v60, s34
  s_mov_b32 s33, 4
L_p1a:
  s_bfe_u32 s68, s70, 0x10000
  s_lshl_b32 s68, s68, 14
  s_bfe_u32 s71, s70, 0x50001
  s_lshl_b32 s71, s71, 16
  s_or_b32 s68, s68, s71
  s_add_u32 s70, s70, 1
  s_waitcnt vmcnt(7)
  v_mfma_f32_16x16x32_bf16 v[36:39], v[76:79], v[4:7], 0
  buffer_load_dwordx4 v[76:79], v1, s[24:27], s68 offen offset:0 nt
  s_waitcnt vmcnt(7)
  v_mfma_f32_16x16x32_bf16 v[40:43], v[80:83], v[4:7], 0
  buffer_load_dwordx4 v[80:83], v1, s[24:27], s68 offen offset:1024 nt
  s_waitcnt vmcnt(7)
  v_mfma_f32_16x16x32_bf16 v[44:47], v[84:87], v[4:7], 0
  buffer_load_dwordx4 v[84:87], v1, s[24:27], s68 offen offset:2048 nt
  s_waitcnt vmcnt(7)
  v_mfma_f32_16x16x32_bf16 v[48:51], v[88:91], v[4:7], 0
  buffer_load_dwordx4 v[88:91], v1, s[24:27], s68 offen offset:3072 nt
  s_nop 0
  v_mul_f32_dpp v28, v36, v60 quad_perm:[0,0,0,0] row_mask:0xf bank_mask:0xf
  v_fmac_f32_dpp v28, v37, v60 quad_perm:[1,1,1,1] row_mask:0xf bank_mask:0xf
  v_fmac_f32_dpp v28, v38, v60 quad_perm:[2,2,2,2] row_mask:0xf bank_mask:0xf
  v_fmac_f32_dpp v28, v39, v60 quad_perm:[3,3,3,3] row_mask:0xf bank_mask:0xf
  v_mul_f32_dpp v29, v40, v60 quad_perm:[0,0,0,0] row_mask:0xf bank_mask:0xf
  v_fmac_f32_dpp v29, v41, v60 quad_perm:[1,1,1,1] row_mask:0xf bank_mask:0xf
  v_fmac_f32_dpp v29, v42, v60 quad_perm:[2,2,2,2] row_mask:0xf bank_mask:0xf
  v_fmac_f32_dpp v29, v43, v60 quad_perm:[3,3,3,3] row_mask:0xf bank_mask:0xf
  v_mul_f32_dpp v30, v44, v60 quad_perm:[0,0,0,0] row_mask:0xf bank_mask:0xf
  v_fmac_f32_dpp v30, v45, v60 quad_perm:[1,1,1,1] row_mask:0xf bank_mask:0xf
  v_fmac_f32_dpp v30, v46, v60 quad_perm:[2,2,2,2] row_mask:0xf bank_mask:0xf
  v_fmac_f32_dpp v30, v47, v60 quad_perm:[3,3,3,3] row_mask:0xf bank_mask:0xf
  s_nop 0
  v_mul_f32_dpp v31, v48, v60 quad_perm:[0,0,0,0] row_mask:0xf bank_mask:0xf
  v_fmac_f32_dpp v31, v49, v60 quad_perm:[1,1,1,1] row_mask:0xf bank_mask:0xf
  v_fmac_f32_dpp v31, v50, v60 quad_perm:[2,2,2,2] row_mask:0xf bank_mask:0xf
  v_fmac_f32_dpp v31, v51, v60 quad_perm:[3,3,3,3] row_mask:0xf bank_mask:0xf
  s_nop 0
  v_max3_f32 v55, v28, v29, v55
  v_max3_f32 v55, v30, v31, v55
  ds_write_b128 v58, v[28:31] offset:0
  s_bfe_u32 s68, s70, 0x10000
  s_lshl_b32 s68, s68, 14
  s_bfe_u32 s71, s70, 0x50001
  s_lshl_b32 s71, s71, 16
  s_or_b32 s68, s68, s71
  s_add_u32 s70, s70, 1
  s_waitcnt vmcnt(7)
  v_mfma_f32_16x16x32_bf16 v[36:39], v[92:95], v[4:7], 0
  buffer_load_dwordx4 v[92:95], v1, s[24:27], s68 offen offset:0 nt
  s_waitcnt vmcnt(7)
  v_mfma_f32_16x16x32_bf16 v[40:43], v[96:99], v[4:7], 0
  buffer_load_dwordx4 v[96:99], v1, s[24:27], s68 offen offset:1024 nt
  s_waitcnt vmcnt(7)
  v_mfma_f32_16x16x32_bf16 v[44:47], v[100:103], v[4:7], 0
  buffer_load_dwordx4 v[100:103], v1, s[24:27], s68 offen offset:2048 nt
  s_waitcnt vmcnt(7)
  v_mfma_f32_16x16x32_bf16 v[48:51], v[104:107], v[4:7], 0
  buffer_load_dwordx4 v[104:107], v1, s[24:27], s68 offen offset:3072 nt
  s_nop 0
  v_mul_f32_dpp v68, v36, v60 quad_perm:[0,0,0,0] row_mask:0xf bank_mask:0xf
  v_fmac_f32_dpp v68, v37, v60 quad_perm:[1,1,1,1] row_mask:0xf bank_mask:0xf
  v_fmac_f32_dpp v68, v38, v60 quad_perm:[2,2,2,2] row_mask:0xf bank_mask:0xf
  v_fmac_f32_dpp v68, v39, v60 quad_perm:[3,3,3,3] row_mask:0xf bank_mask:0xf
  v_mul_f32_dpp v69, v40, v60 quad_perm:[0,0,0,0] row_mask:0xf bank_mask:0xf
  v_fmac_f32_dpp v69, v41, v60 quad_perm:[1,1,1,1] row_mask:0xf bank_mask:0xf
  v_fmac_f32_dpp v69, v42, v60 quad_perm:[2,2,2,2] row_mask:0xf bank_mask:0xf
  v_fmac_f32_dpp v69, v43, v60 quad_perm:[3,3,3,3] row_mask:0xf bank_mask:0xf
  v_mul_f32_dpp v70, v44, v60 quad_perm:[0,0,0,0] row_mask:0xf bank_mask:0xf
  v_fmac_f32_dpp v70, v45, v60 quad_perm:[1,1,1,1] row_mask:0xf bank_mask:0xf
  v_fmac_f32_dpp v70, v46, v60 quad_perm:[2,2,2,2] row_mask:0xf bank_mask:0xf
  v_fmac_f32_dpp v70, v47, v60 quad_perm:[3,3,3,3] row_mask:0xf bank_mask:0xf
  s_nop 0
  v_mul_f32_dpp v71, v48, v60 quad_perm:[0,0,0,0] row_mask:0xf bank_mask:0xf
  v_fmac_f32_dpp v71, v49, v60 quad_perm:[1,1,1,1] row_mask:0xf bank_mask:0xf
  v_fmac_f32_dpp v71, v50, v60 quad_perm:[2,2,2,2] row_mask:0xf bank_mask:0xf
  v_fmac_f32_dpp v71, v51, v60 quad_perm:[3,3,3,3] row_mask:0xf bank_mask:0xf
  s_nop 0
  v_max3_f32 v55, v68, v69, v55
  v_max3_f32 v55, v70, v71, v55
  ds_write_b128 v58, v[68:71] offset:128
  v_add_u32 v58, 256, v58
  s_sub_u32 s33, s33, 1
  s_cmp_lg_u32 s33, 0
  s_cbranch_scc1 L_p1a
  s_mov_b32 s33, 27
L_p1:
  s_bfe_u32 s68, s70, 0x10000
  s_lshl_b32 s68, s68, 14
  s_bfe_u32 s71, s70, 0x50001
  s_lshl_b32 s71, s71, 16
  s_or_b32 s68, s68, s71
  s_add_u32 s70, s70, 1
  s_waitcnt vmcnt(4)
  v_mfma_f32_16x16x32_bf16 v[36:39], v[76:79], v[4:7], 0
  buffer_load_dwordx4 v[76:79], v1, s[24:27], s68 offen offset:0 nt
  s_waitcnt vmcnt(4)
  v_mfma_f32_16x16x32_bf16 v[40:43], v[80:83], v[4:7], 0
  buffer_load_dwordx4 v[80:83], v1, s[24:27], s68 offen offset:1024 nt
  s_waitcnt vmcnt(4)
  v_mfma_f32_16x16x32_bf16 v[44:47], v[84:87], v[4:7], 0
  buffer_load_dwordx4 v[84:87], v1, s[24:27], s68 offen offset:2048 nt
  s_waitcnt vmcnt(4)
  v_mfma_f32_16x16x32_bf16 v[48:51], v[88:91], v[4:7], 0
  buffer_load_dwordx4 v[88:91], v1, s[24:27], s68 offen offset:3072 nt
  s_nop 0
  v_mul_f32_dpp v28, v36, v60 quad_perm:[0,0,0,0] row_mask:0xf bank_mask:0xf
  v_fmac_f32_dpp v28, v37, v60 quad_perm:[1,1,1,1] row_mask:0xf bank_mask:0xf
  v_fmac_f32_dpp v28, v38, v60 quad_perm:[2,2,2,2] row_mask:0xf bank_mask:0xf
  v_fmac_f32_dpp v28, v39, v60 quad_perm:[3,3,3,3] row_mask:0xf bank_mask:0xf
  v_mul_f32_dpp v29, v40, v60 quad_perm:[0,0,0,0] row_mask:0xf bank_mask:0xf
  v_fmac_f32_dpp v29, v41, v60 quad_perm:[1,1,1,1] row_mask:0xf bank_mask:0xf
  v_fmac_f32_dpp v29, v42, v60 quad_perm:[2,2,2,2] row_mask:0xf bank_mask:0xf
  v_fmac_f32_dpp v29, v43, v60 quad_perm:[3,3,3,3] row_mask:0xf bank_mask:0xf
  v_mul_f32_dpp v30, v44, v60 quad_perm:[0,0,0,0] row_mask:0xf bank_mask:0xf
  v_fmac_f32_dpp v30, v45, v60 quad_perm:[1,1,1,1] row_mask:0xf bank_mask:0xf
  v_fmac_f32_dpp v30, v46, v60 quad_perm:[2,2,2,2] row_mask:0xf bank_mask:0xf
  v_fmac_f32_dpp v30, v47, v60 quad_perm:[3,3,3,3] row_mask:0xf bank_mask:0xf
  s_nop 0
  v_mul_f32_dpp v31, v48, v60 quad_perm:[0,0,0,0] row_mask:0xf bank_mask:0xf
  v_fmac_f32_dpp v31, v49, v60 quad_perm:[1,1,1,1] row_mask:0xf bank_mask:0xf
  v_fmac_f32_dpp v31, v50, v60 quad_perm:[2,2,2,2] row_mask:0xf bank_mask:0xf
  v_fmac_f32_dpp v31, v51, v60 quad_perm:[3,3,3,3] row_mask:0xf bank_mask:0xf
  s_nop 0
  v_max3_f32 v55, v28, v29, v55
  v_max3_f32 v55, v30, v31, v55
  ds_write_b128 v58, v[28:31] offset:0
  s_bfe_u32 s68, s70, 0x10000
  s_lshl_b32 s68, s68, 14
  s_bfe_u32 s71, s70, 0x50001
  s_lshl_b32 s71, s71, 16
  s_or_b32 s68, s68, s71
  s_add_u32 s70, s70, 1
  s_waitcnt vmcnt(4)
  v_mfma_f32_16x16x32_bf16 v[36:39], v[92:95], v[4:7], 0
  buffer_load_dwordx4 v[92:95], v1, s[24:27], s68 offen offset:0 nt
  s_waitcnt vmcnt(4)
  v_mfma_f32_16x16x32_bf16 v[40:43], v[96:99], v[4:7], 0
  buffer_load_dwordx4 v[96:99], v1, s[24:27], s68 offen offset:1024 nt
  s_waitcnt vmcnt(4)
  v_mfma_f32_16x16x32_bf16 v[44:47], v[100:103], v[4:7], 0
  buffer_load_dwordx4 v[100:103], v1, s[24:27], s68 offen offset:2048 nt
  s_waitcnt vmcnt(4)
  v_mfma_f32_16x16x32_bf16 v[48:51], v[104:107], v[4:7], 0
  buffer_load_dwordx4 v[104:107], v1, s[24:27], s68 offen offset:3072 nt
  s_nop 0
  v_mul_f32_dpp v68, v36, v60 quad_perm:[0,0,0,0] row_mask:0xf bank_mask:0xf
  v_fmac_f32_dpp v68, v37, v60 quad_perm:[1,1,1,1] row_mask:0xf bank_mask:0xf
  v_fmac_f32_dpp v68, v38, v60 quad_perm:[2,2,2,2] row_mask:0xf bank_mask:0xf
  v_fmac_f32_dpp v68, v39, v60 quad_perm:[3,3,3,3] row_mask:0xf bank_mask:0xf
  v_mul_f32_dpp v69, v40, v60 quad_perm:[0,0,0,0] row_mask:0xf bank_mask:0xf
  v_fmac_f32_dpp v69, v41, v60 quad_perm:[1,1,1,1] row_mask:0xf bank_mask:0xf
  v_fmac_f32_dpp v69, v42, v60 quad_perm:[2,2,2,2] row_mask:0xf bank_mask:0xf
  v_fmac_f32_dpp v69, v43, v60 quad_perm:[3,3,3,3] row_mask:0xf bank_mask:0xf
  v_mul_f32_dpp v70, v44, v60 quad_perm:[0,0,0,0] row_mask:0xf bank_mask:0xf
  v_fmac_f32_dpp v70, v45, v60 quad_perm:[1,1,1,1] row_mask:0xf bank_mask:0xf
  v_fmac_f32_dpp v70, v46, v60 quad_perm:[2,2,2,2] row_mask:0xf bank_mask:0xf
  v_fmac_f32_dpp v70, v47, v60 quad_perm:[3,3,3,3] row_mask:0xf bank_mask:0xf
  s_nop 0
  v_mul_f32_dpp v71, v48, v60 quad_perm:[0,0,0,0] row_mask:0xf bank_mask:0xf
  v_fmac_f32_dpp v71, v49, v60 quad_perm:[1,1,1,1] row_mask:0xf bank_mask:0xf
  v_fmac_f32_dpp v71, v50, v60 quad_perm:[2,2,2,2] row_mask:0xf bank_mask:0xf
  v_fmac_f32_dpp v71, v51, v60 quad_perm:[3,3,3,3] row_mask:0xf bank_mask:0xf
  s_nop 0
  v_max3_f32 v55, v68, v69, v55
  v_max3_f32 v55, v70, v71, v55
  ds_write_b128 v58, v[68:71] offset:128
  v_add_u32 v58, 256, v58
  s_sub_u32 s33, s33, 1
  s_cmp_lg_u32 s33, 0
  s_cbranch_scc1 L_p1
  s_mov_b32 s70, 0
  s_bfe_u32 s68, s70, 0x10000
  s_lshl_b32 s68, s68, 14
  s_bfe_u32 s71, s70, 0x50001
  s_lshl_b32 s71, s71, 16
  s_or_b32 s68, s68, s71
  s_add_u32 s70, s70, 1
  s_waitcnt vmcnt(4)
  v_mfma_f32_16x16x32_bf16 v[36:39], v[76:79], v[4:7], 0
  buffer_load_dwordx4 v[76:79], v2, s[28:31], s68 offen offset:0 nt
  s_waitcnt vmcnt(4)
  v_mfma_f32_16x16x32_bf16 v[40:43], v[80:83], v[4:7], 0
  buffer_load_dwordx4 v[80:83], v2, s[28:31], s68 offen offset:1024 nt
  s_waitcnt vmcnt(4)
  v_mfma_f32_16x16x32_bf16 v[44:47], v[84:87], v[4:7], 0
  buffer_load_dwordx4 v[84:87], v2, s[28:31], s68 offen offset:2048 nt
  s_waitcnt vmcnt(4)
  v_mfma_f32_16x16x32_bf16 v[48:51], v[88:91], v[4:7], 0
  buffer_load_dwordx4 v[88:91], v2, s[28:31], s68 offen offset:3072 nt
  s_nop 0
  v_mul_f32_dpp v28, v36, v60 quad_perm:[0,0,0,0] row_mask:0xf bank_mask:0xf
  v_fmac_f32_dpp v28, v37, v60 quad_perm:[1,1,1,1] row_mask:0xf bank_mask:0xf
  v_fmac_f32_dpp v28, v38, v60 quad_perm:[2,2,2,2] row_mask:0xf bank_mask:0xf
  v_fmac_f32_dpp v28, v39, v60 quad_perm:[3,3,3,3] row_mask:0xf bank_mask:0xf
  v_mul_f32_dpp v29, v40, v60 quad_perm:[0,0,0,0] row_mask:0xf bank_mask:0xf
  v_fmac_f32_dpp v29, v41, v60 quad_perm:[1,1,1,1] row_mask:0xf bank_mask:0xf
  v_fmac_f32_dpp v29, v42, v60 quad_perm:[2,2,2,2] row_mask:0xf bank_mask:0xf
  v_fmac_f32_dpp v29, v43, v60 quad_perm:[3,3,3,3] row_mask:0xf bank_mask:0xf
  v_mul_f32_dpp v30, v44, v60 quad_perm:[0,0,0,0] row_mask:0xf bank_mask:0xf
  v_fmac_f32_dpp v30, v45, v60 quad_perm:[1,1,1,1] row_mask:0xf bank_mask:0xf
  v_fmac_f32_dpp v30, v46, v60 quad_perm:[2,2,2,2] row_mask:0xf bank_mask:0xf
  v_fmac_f32_dpp v30, v47, v60 quad_perm:[3,3,3,3] row_mask:0xf bank_mask:0xf
  s_nop 0
  v_mul_f32_dpp v31, v48, v60 quad_perm:[0,0,0,0] row_mask:0xf bank_mask:0xf
  v_fmac_f32_dpp v31, v49, v60 quad_perm:[1,1,1,1] row_mask:0xf bank_mask:0xf
  v_fmac_f32_dpp v31, v50, v60 quad_perm:[2,2,2,2] row_mask:0xf bank_mask:0xf
  v_fmac_f32_dpp v31, v51, v60 quad_perm:[3,3,3,3] row_mask:0xf bank_mask:0xf
  s_nop 0
  v_max3_f32 v55, v28, v29, v55
  v_max3_f32 v55, v30, v31, v55
  ds_write_b128 v58, v[28:31] offset:0
  s_bfe_u32 s68, s70, 0x10000
  s_lshl_b32 s68, s68, 14
  s_bfe_u32 s71, s70, 0x50001
  s_lshl_b32 s71, s71, 16
  s_or_b32 s68, s68, s71
  s_add_u32 s70, s70, 1
  s_waitcnt vmcnt(4)
  v_mfma_f32_16x16x32_bf16 v[36:39], v[92:95], v[4:7], 0
  buffer_load_dwordx4 v[92:95], v2, s[28:31], s68 offen offset:0 nt
  s_waitcnt vmcnt(4)
  v_mfma_f32_16x16x32_bf16 v[40:43], v[96:99], v[4:7], 0
  buffer_load_dwordx4 v[96:99], v2, s[28:31], s68 offen offset:1024 nt
  s_waitcnt vmcnt(4)
  v_mfma_f32_16x16x32_bf16 v[44:47], v[100:103], v[4:7], 0
  buffer_load_dwordx4 v[100:103], v2, s[28:31], s68 offen offset:2048 nt
  s_waitcnt vmcnt(4)
  v_mfma_f32_16x16x32_bf16 v[48:51], v[104:107], v[4:7], 0
  buffer_load_dwordx4 v[104:107], v2, s[28:31], s68 offen offset:3072 nt
  s_nop 0
  v_mul_f32_dpp v68, v36, v60 quad_perm:[0,0,0,0] row_mask:0xf bank_mask:0xf
  v_fmac_f32_dpp v68, v37, v60 quad_perm:[1,1,1,1] row_mask:0xf bank_mask:0xf
  v_fmac_f32_dpp v68, v38, v60 quad_perm:[2,2,2,2] row_mask:0xf bank_mask:0xf
  v_fmac_f32_dpp v68, v39, v60 quad_perm:[3,3,3,3] row_mask:0xf bank_mask:0xf
  v_mul_f32_dpp v69, v40, v60 quad_perm:[0,0,0,0] row_mask:0xf bank_mask:0xf
  v_fmac_f32_dpp v69, v41, v60 quad_perm:[1,1,1,1] row_mask:0xf bank_mask:0xf
  v_fmac_f32_dpp v69, v42, v60 quad_perm:[2,2,2,2] row_mask:0xf bank_mask:0xf
  v_fmac_f32_dpp v69, v43, v60 quad_perm:[3,3,3,3] row_mask:0xf bank_mask:0xf
  v_mul_f32_dpp v70, v44, v60 quad_perm:[0,0,0,0] row_mask:0xf bank_mask:0xf
  v_fmac_f32_dpp v70, v45, v60 quad_perm:[1,1,1,1] row_mask:0xf bank_mask:0xf
  v_fmac_f32_dpp v70, v46, v60 quad_perm:[2,2,2,2] row_mask:0xf bank_mask:0xf
  v_fmac_f32_dpp v70, v47, v60 quad_perm:[3,3,3,3] row_mask:0xf bank_mask:0xf
  s_nop 0
  v_mul_f32_dpp v71, v48, v60 quad_perm:[0,0,0,0] row_mask:0xf bank_mask:0xf
  v_fmac_f32_dpp v71, v49, v60 quad_perm:[1,1,1,1] row_mask:0xf bank_mask:0xf
  v_fmac_f32_dpp v71, v50, v60 quad_perm:[2,2,2,2] row_mask:0xf bank_mask:0xf
  v_fmac_f32_dpp v71, v51, v60 quad_perm:[3,3,3,3] row_mask:0xf bank_mask:0xf
  s_nop 0
  v_max3_f32 v55, v68, v69, v55
  v_max3_f32 v55, v70, v71, v55
  ds_write_b128 v58, v[68:71] offset:128
  v_subrev_u32 v58, 7936, v58
  v_mov_b32 v56, v55
  s_nop 1
  v_permlane16_swap_b32 v55, v56
  s_nop 1
  v_max_f32 v55, v55, v56
  v_mov_b32 v56, v55
  s_nop 1
  v_permlane32_swap_b32 v55, v56
  s_nop 1
  v_max_f32 v55, v55, v56
  v_max_f32 v52, v55, v57
  v_sub_f32 v53, 0, v52
  v_add_f32 v56, v57, v53
  v_exp_f32 v56, v56
  v_cmp_gt_u32 vcc, 16, v59
  s_nop 1
  v_cndmask_b32 v54, 0, v56, vcc
  v_mul_f32 v24, v56, v64
  v_mul_f32 v25, v56, v65
  v_mul_f32 v26, v56, v66
  v_mul_f32 v27, v56, v67
  s_waitcnt lgkmcnt(0)
  ds_read_b128 v[28:31], v58
  s_mov_b32 s33, 24
L_p2_0:
  ds_read_b128 v[68:71], v58 offset:128
  s_waitcnt lgkmcnt(1)
  v_add_f32 v32, v28, v53
  v_add_f32 v33, v29, v53
  v_add_f32 v34, v30, v53
  v_add_f32 v35, v31, v53
  v_exp_f32 v32, v32
  v_exp_f32 v33, v33
  v_exp_f32 v34, v34
  v_exp_f32 v35, v35
  s_nop 0
  v_add_f32 v54, v54, v32
  v_add_f32 v54, v54, v33
  v_add_f32 v54, v54, v34
  v_add_f32 v54, v54, v35
  v_cvt_pk_bf16_f32 v32, v32, v32
  v_cvt_pk_bf16_f32 v33, v33, v33
  v_cvt_pk_bf16_f32 v34, v34, v34
  v_cvt_pk_bf16_f32 v35, v35, v35
  v_and_b32 v36, v32, v20
  v_and_b32 v37, v32, v21
  v_and_b32 v38, v32, v22
  v_and_b32 v39, v32, v23
  v_and_b32 v40, v33, v20
  v_and_b32 v41, v33, v21
  v_and_b32 v42, v33, v22
  v_and_b32 v43, v33, v23
  v_and_b32 v44, v34, v20
  v_and_b32 v45, v34, v21
  v_and_b32 v46, v34, v22
  v_and_b32 v47, v34, v23
  v_and_b32 v48, v35, v20
  v_and_b32 v49, v35, v21
  v_and_b32 v50, v35, v22
  v_and_b32 v51, v35, v23
  s_bfe_u32 s68, s70, 0x10000
  s_lshl_b32 s68, s68, 14
  s_bfe_u32 s71, s70, 0x50001
  s_lshl_b32 s71, s71, 16
  s_or_b32 s68, s68, s71
  s_add_u32 s70, s70, 1
  s_waitcnt vmcnt(4)
  v_mfma_f32_16x16x32_bf16 v[24:27], v[76:79], v[36:39], v[24:27]
  buffer_load_dwordx4 v[76:79], v2, s[28:31], s68 offen offset:0 nt
  s_waitcnt vmcnt(4)
  v_mfma_f32_16x16x32_bf16 v[24:27], v[80:83], v[40:43], v[24:27]
  buffer_load_dwordx4 v[80:83], v2, s[28:31], s68 offen offset:1024 nt
  s_waitcnt vmcnt(4)
  v_mfma_f32_16x16x32_bf16 v[24:27], v[84:87], v[44:47], v[24:27]
  buffer_load_dwordx4 v[84:87], v2, s[28:31], s68 offen offset:2048 nt
  s_waitcnt vmcnt(4)
  v_mfma_f32_16x16x32_bf16 v[24:27], v[88:91], v[48:51], v[24:27]
  buffer_load_dwordx4 v[88:91], v2, s[28:31], s68 offen offset:3072 nt
  ds_read_b128 v[28:31], v58 offset:256
  s_waitcnt lgkmcnt(1)
  v_add_f32 v32, v68, v53
  v_add_f32 v33, v69, v53
  v_add_f32 v34, v70, v53
  v_add_f32 v35, v71, v53
  v_exp_f32 v32, v32
  v_exp_f32 v33, v33
  v_exp_f32 v34, v34
  v_exp_f32 v35, v35
  s_nop 0
  v_add_f32 v54, v54, v32
  v_add_f32 v54, v54, v33
  v_add_f32 v54, v54, v34
  v_add_f32 v54, v54, v35
  v_cvt_pk_bf16_f32 v32, v32, v32
  v_cvt_pk_bf16_f32 v33, v33, v33
  v_cvt_pk_bf16_f32 v34, v34, v34
  v_cvt_pk_bf16_f32 v35, v35, v35
  v_and_b32 v36, v32, v20
  v_and_b32 v37, v32, v21
  v_and_b32 v38, v32, v22
  v_and_b32 v39, v32, v23
  v_and_b32 v40, v33, v20
  v_and_b32 v41, v33, v21
  v_and_b32 v42, v33, v22
  v_and_b32 v43, v33, v23
  v_and_b32 v44, v34, v20
  v_and_b32 v45, v34, v21
  v_and_b32 v46, v34, v22
  v_and_b32 v47, v34, v23
  v_and_b32 v48, v35, v20
  v_and_b32 v49, v35, v21
  v_and_b32 v50, v35, v22
  v_and_b32 v51, v35, v23
  s_bfe_u32 s68, s70, 0x10000
  s_lshl_b32 s68, s68, 14
  s_bfe_u32 s71, s70, 0x50001
  s_lshl_b32 s71, s71, 16
  s_or_b32 s68, s68, s71
  s_add_u32 s70, s70, 1
  s_waitcnt vmcnt(4)
  v_mfma_f32_16x16x32_bf16 v[24:27], v[92:95], v[36:39], v[24:27]
  buffer_load_dwordx4 v[92:95], v2, s[28:31], s68 offen offset:0 nt
  s_waitcnt vmcnt(4)
  v_mfma_f32_16x16x32_bf16 v[24:27], v[96:99], v[40:43], v[24:27]
  buffer_load_dwordx4 v[96:99], v2, s[28:31], s68 offen offset:1024 nt
  s_waitcnt vmcnt(4)
  v_mfma_f32_16x16x32_bf16 v[24:27], v[100:103], v[44:47], v[24:27]
  buffer_load_dwordx4 v[100:103], v2, s[28:31], s68 offen offset:2048 nt
  s_waitcnt vmcnt(4)
  v_mfma_f32_16x16x32_bf16 v[24:27], v[104:107], v[48:51], v[24:27]
  buffer_load_dwordx4 v[104:107], v2, s[28:31], s68 offen offset:3072 nt
  v_add_u32 v58, 256, v58
  s_sub_u32 s33, s33, 1
  s_cmp_lg_u32 s33, 0
  s_cbranch_scc1 L_p2_0
  s_mov_b32 s33, 7
L_p2_1:
  ds_read_b128 v[68:71], v58 offset:128
  s_waitcnt lgkmcnt(1)
  v_add_f32 v32, v28, v53
  v_add_f32 v33, v29, v53
  v_add_f32 v34, v30, v53
  v_add_f32 v35, v31, v53
  v_exp_f32 v32, v32
  v_exp_f32 v33, v33
  v_exp_f32 v34, v34
  v_exp_f32 v35, v35
  s_nop 0
  v_add_f32 v54, v54, v32
  v_add_f32 v54, v54, v33
  v_add_f32 v54, v54, v34
  v_add_f32 v54, v54, v35
  v_cvt_pk_bf16_f32 v32, v32, v32
  v_cvt_pk_bf16_f32 v33, v33, v33
  v_cvt_pk_bf16_f32 v34, v34, v34
  v_cvt_pk_bf16_f32 v35, v35, v35
  v_and_b32 v36, v32, v20
  v_and_b32 v37, v32, v21
  v_and_b32 v38, v32, v22
  v_and_b32 v39, v32, v23
  v_and_b32 v40, v33, v20
  v_and_b32 v41, v33, v21
  v_and_b32 v42, v33, v22
  v_and_b32 v43, v33, v23
  v_and_b32 v44, v34, v20
  v_and_b32 v45, v34, v21
  v_and_b32 v46, v34, v22
  v_and_b32 v47, v34, v23
  v_and_b32 v48, v35, v20
  v_and_b32 v49, v35, v21
  v_and_b32 v50, v35, v22
  v_and_b32 v51, v35, v23
  s_bfe_u32 s68, s70, 0x10000
  s_lshl_b32 s68, s68, 14
  s_bfe_u32 s71, s70, 0x50001
  s_lshl_b32 s71, s71, 16
  s_or_b32 s68, s68, s71
  s_add_u32 s70, s70, 1
  s_waitcnt vmcnt(7)
  v_mfma_f32_16x16x32_bf16 v[24:27], v[76:79], v[36:39], v[24:27]
  buffer_load_dwordx4 v[76:79], v2, s[28:31], s68 offen offset:0 nt
  s_waitcnt vmcnt(7)
  v_mfma_f32_16x16x32_bf16 v[24:27], v[80:83], v[40:43], v[24:27]
  buffer_load_dwordx4 v[80:83], v2, s[28:31], s68 offen offset:1024 nt
  s_waitcnt vmcnt(7)
  v_mfma_f32_16x16x32_bf16 v[24:27], v[84:87], v[44:47], v[24:27]
  buffer_load_dwordx4 v[84:87], v2, s[28:31], s68 offen offset:2048 nt
  s_waitcnt vmcnt(7)
  v_mfma_f32_16x16x32_bf16 v[24:27], v[88:91], v[48:51], v[24:27]
  buffer_load_dwordx4 v[88:91], v2, s[28:31], s68 offen offset:3072 nt
  ds_read_b128 v[28:31], v58 offset:256
  s_waitcnt lgkmcnt(1)
  v_add_f32 v32, v68, v53
  v_add_f32 v33, v69, v53
  v_add_f32 v34, v70, v53
  v_add_f32 v35, v71, v53
  v_exp_f32 v32, v32
  v_exp_f32 v33, v33
  v_exp_f32 v34, v34
  v_exp_f32 v35, v35
  s_nop 0
  v_add_f32 v54, v54, v32
  v_add_f32 v54, v54, v33
  v_add_f32 v54, v54, v34
  v_add_f32 v54, v54, v35
  v_cvt_pk_bf16_f32 v32, v32, v32
  v_cvt_pk_bf16_f32 v33, v33, v33
  v_cvt_pk_bf16_f32 v34, v34, v34
  v_cvt_pk_bf16_f32 v35, v35, v35
  v_and_b32 v36, v32, v20
  v_and_b32 v37, v32, v21
  v_and_b32 v38, v32, v22
  v_and_b32 v39, v32, v23
  v_and_b32 v40, v33, v20
  v_and_b32 v41, v33, v21
  v_and_b32 v42, v33, v22
  v_and_b32 v43, v33, v23
  v_and_b32 v44, v34, v20
  v_and_b32 v45, v34, v21
  v_and_b32 v46, v34, v22
  v_and_b32 v47, v34, v23
  v_and_b32 v48, v35, v20
  v_and_b32 v49, v35, v21
  v_and_b32 v50, v35, v22
  v_and_b32 v51, v35, v23
  s_bfe_u32 s68, s70, 0x10000
  s_lshl_b32 s68, s68, 14
  s_bfe_u32 s71, s70, 0x50001
  s_lshl_b32 s71, s71, 16
  s_or_b32 s68, s68, s71
  s_add_u32 s70, s70, 1
  s_waitcnt vmcnt(7)
  v_mfma_f32_16x16x32_bf16 v[24:27], v[92:95], v[36:39], v[24:27]
  buffer_load_dwordx4 v[92:95], v2, s[28:31], s68 offen offset:0 nt
  s_waitcnt vmcnt(7)
  v_mfma_f32_16x16x32_bf16 v[24:27], v[96:99], v[40:43], v[24:27]
  buffer_load_dwordx4 v[96:99], v2, s[28:31], s68 offen offset:1024 nt
  s_waitcnt vmcnt(7)
  v_mfma_f32_16x16x32_bf16 v[24:27], v[100:103], v[44:47], v[24:27]
  buffer_load_dwordx4 v[100:103], v2, s[28:31], s68 offen offset:2048 nt
  s_waitcnt vmcnt(7)
  v_mfma_f32_16x16x32_bf16 v[24:27], v[104:107], v[48:51], v[24:27]
  buffer_load_dwordx4 v[104:107], v2, s[28:31], s68 offen offset:3072 nt
  v_add_u32 v58, 256, v58
  s_sub_u32 s33, s33, 1
  s_cmp_lg_u32 s33, 0
  s_cbranch_scc1 L_p2_1
  ds_read_b128 v[68:71], v58 offset:128
  s_waitcnt lgkmcnt(1)
  v_add_f32 v32, v28, v53
  v_add_f32 v33, v29, v53
  v_add_f32 v34, v30, v53
  v_add_f32 v35, v31, v53
  v_exp_f32 v32, v32
  v_exp_f32 v33, v33
  v_exp_f32 v34, v34
  v_exp_f32 v35, v35
  s_nop 0
  v_add_f32 v54, v54, v32
  v_add_f32 v54, v54, v33
  v_add_f32 v54, v54, v34
  v_add_f32 v54, v54, v35
  v_cvt_pk_bf16_f32 v32, v32, v32
  v_cvt_pk_bf16_f32 v33, v33, v33
  v_cvt_pk_bf16_f32 v34, v34, v34
  v_cvt_pk_bf16_f32 v35, v35, v35
  v_and_b32 v36, v32, v20
  v_and_b32 v37, v32, v21
  v_and_b32 v38, v32, v22
  v_and_b32 v39, v32, v23
  v_and_b32 v40, v33, v20
  v_and_b32 v41, v33, v21
  v_and_b32 v42, v33, v22
  v_and_b32 v43, v33, v23
  v_and_b32 v44, v34, v20
  v_and_b32 v45, v34, v21
  v_and_b32 v46, v34, v22
  v_and_b32 v47, v34, v23
  v_and_b32 v48, v35, v20
  v_and_b32 v49, v35, v21
  v_and_b32 v50, v35, v22
  v_and_b32 v51, v35, v23
  s_waitcnt vmcnt(7)
  v_mfma_f32_16x16x32_bf16 v[24:27], v[76:79], v[36:39], v[24:27]
  s_waitcnt vmcnt(6)
  v_mfma_f32_16x16x32_bf16 v[24:27], v[80:83], v[40:43], v[24:27]
  s_waitcnt vmcnt(5)
  v_mfma_f32_16x16x32_bf16 v[24:27], v[84:87], v[44:47], v[24:27]
  s_waitcnt vmcnt(4)
  v_mfma_f32_16x16x32_bf16 v[24:27], v[88:91], v[48:51], v[24:27]
  s_waitcnt lgkmcnt(0)
  v_add_f32 v32, v68, v53
  v_add_f32 v33, v69, v53
  v_add_f32 v34, v70, v53
  v_add_f32 v35, v71, v53
  v_exp_f32 v32, v32
  v_exp_f32 v33, v33
  v_exp_f32 v34, v34
  v_exp_f32 v35, v35
  s_nop 0
  v_add_f32 v54, v54, v32
  v_add_f32 v54, v54, v33
  v_add_f32 v54, v54, v34
  v_add_f32 v54, v54, v35
  v_cvt_pk_bf16_f32 v32, v32, v32
  v_cvt_pk_bf16_f32 v33, v33, v33
  v_cvt_pk_bf16_f32 v34, v34, v34
  v_cvt_pk_bf16_f32 v35, v35, v35
  v_and_b32 v36, v32, v20
  v_and_b32 v37, v32, v21
  v_and_b32 v38, v32, v22
  v_and_b32 v39, v32, v23
  v_and_b32 v40, v33, v20
  v_and_b32 v41, v33, v21
  v_and_b32 v42, v33, v22
  v_and_b32 v43, v33, v23
  v_and_b32 v44, v34, v20
  v_and_b32 v45, v34, v21
  v_and_b32 v46, v34, v22
  v_and_b32 v47, v34, v23
  v_and_b32 v48, v35, v20
  v_and_b32 v49, v35, v21
  v_and_b32 v50, v35, v22
  v_and_b32 v51, v35, v23
  s_waitcnt vmcnt(3)
  v_mfma_f32_16x16x32_bf16 v[24:27], v[92:95], v[36:39], v[24:27]
  s_waitcnt vmcnt(2)
  v_mfma_f32_16x16x32_bf16 v[24:27], v[96:99], v[40:43], v[24:27]
  s_waitcnt vmcnt(1)
  v_mfma_f32_16x16x32_bf16 v[24:27], v[100:103], v[44:47], v[24:27]
  s_waitcnt vmcnt(0)
  v_mfma_f32_16x16x32_bf16 v[24:27], v[104:107], v[48:51], v[24:27]
  s_lshr_b32 s36, s22, 1
  s_lshl_b32 s36, s36, 2
  v_mov_b32 v12, s36
  v_mov_b32 v13, 0
  s_cmp_lg_u32 s3, 0
  s_cbranch_scc1 L_noearly
  s_mov_b64 exec, 1
  global_atomic_add v14, v12, v13, s[18:19] sc0
  s_mov_b64 exec, -1
L_noearly:
  v_mov_b32 v56, v54
  s_nop 1
  v_permlane16_swap_b32 v54, v56
  s_nop 1
  v_add_f32 v54, v54, v56
  v_mov_b32 v56, v54
  s_nop 1
  v_permlane32_swap_b32 v54, v56
  s_nop 1
  v_add_f32 v54, v54, v56
  v_lshrrev_b32 v60, 4, v59
  v_and_b32 v61, 15, v59
  v_lshrrev_b32 v62, 3, v61
  v_lshlrev_b32 v62, 9, v62
  v_lshl_add_u32 v62, v60, 7, v62
  v_and_b32 v63, 7, v61
  v_lshl_add_u32 v62, v63, 2, v62
  s_lshl_b32 s36, s3, 10
  s_add_u32 s36, s36, 32768
  v_add_u32 v62, s36, v62
  ds_write_b32 v62, v24 offset:0
  ds_write_b32 v62, v25 offset:32
  ds_write_b32 v62, v26 offset:64
  ds_write_b32 v62, v27 offset:96
  v_lshrrev_b32 v63, 3, v61
  v_lshlrev_b32 v63, 3, v63
  s_lshl_b32 s36, s3, 4
  s_add_u32 s36, s36, 36864
  v_add_u32 v63, s36, v63
  v_mov_b32 v60, v52
  v_mov_b32 v61, v54
  ds_write_b64 v63, v[60:61]
  s_waitcnt lgkmcnt(0)
  s_barrier
  s_cmp_lg_u32 s3, 0
  s_cbranch_scc1 L_end
  s_lshr_b32 s36, s22, 1
  s_lshl_b32 s36, s36, 2
  s_and_b32 s37, s22, 1
  s_lshl_b32 s37, s37, 4
  v_mov_b32 v12, s36
  v_lshlrev_b32 v1, 4, v59
  v_lshrrev_b32 v2, 5, v59
  v_lshlrev_b32 v2, 3, v2
  v_add_u32 v2, 36864, v2
  v_add_u32 v3, 32768, v1
  ds_read_b64 v[92:93], v2 offset:0
  ds_read_b64 v[94:95], v2 offset:16
  ds_read_b64 v[96:97], v2 offset:32
  ds_read_b64 v[98:99], v2 offset:48
  ds_read_b128 v[76:79], v3 offset:0
  ds_read_b128 v[80:83], v3 offset:1024
  ds_read_b128 v[84:87], v3 offset:2048
  ds_read_b128 v[88:91], v3 offset:3072
  s_mul_i32 s42, s22, 2
  s_add_u32 s43, s42, s23
  s_lshl_b32 s43, s43, 11
  s_add_u32 s40, s20, s43
  s_addc_u32 s41, s21, 0
  s_xor_b32 s43, s43, 2048
  s_add_u32 s72, s20, s43
  s_addc_u32 s73, s21, 0
  s_waitcnt lgkmcnt(0)
  v_mov_b32 v8, v92
  v_max_f32 v8, v8, v94
  v_max_f32 v8, v8, v96
  v_max_f32 v8, v8, v98
  v_sub_f32 v92, v92, v8
  v_sub_f32 v94, v94, v8
  v_sub_f32 v96, v96, v8
  v_sub_f32 v98, v98, v8
  v_exp_f32 v92, v92
  v_exp_f32 v94, v94
  v_exp_f32 v96, v96
  v_exp_f32 v98, v98
  s_nop 0
  v_mul_f32 v9, v92, v93
  v_fmac_f32 v9, v94, v95
  v_fmac_f32 v9, v96, v97
  v_fmac_f32 v9, v98, v99
  v_mul_f32 v4, v92, v76
  v_mul_f32 v5, v92, v77
  v_mul_f32 v6, v92, v78
  v_mul_f32 v7, v92, v79
  v_fmac_f32 v4, v94, v80
  v_fmac_f32 v5, v94, v81
  v_fmac_f32 v6, v94, v82
  v_fmac_f32 v7, v94, v83
  v_fmac_f32 v4, v96, v84
  v_fmac_f32 v5, v96, v85
  v_fmac_f32 v6, v96, v86
  v_fmac_f32 v7, v96, v87
  v_fmac_f32 v4, v98, v88
  v_fmac_f32 v5, v98, v89
  v_fmac_f32 v6, v98, v90
  v_fmac_f32 v7, v98, v91
  v_mov_b32 v10, 0
  v_mov_b32 v11, 0
  global_store_dwordx4 v1, v[4:7], s[40:41] sc1
  global_store_dwordx4 v1, v[8:11], s[40:41] offset:1024 sc1
  s_waitcnt vmcnt(2)
  v_readfirstlane_b32 s43, v14
  s_nop 3
  s_lshr_b32 s43, s43, s37
  s_and_b32 s43, s43, 0xff
  s_cmp_lg_u32 s43, 0
  s_cbranch_scc1 L_combine
  s_waitcnt vmcnt(0)
  s_lshl_b32 s42, 1, s37
  v_mov_b32 v13, s42
  s_mov_b64 exec, 1
  global_atomic_add v14, v12, v13, s[18:19] sc0
  s_waitcnt vmcnt(0)
  v_readfirstlane_b32 s43, v14
  s_mov_b64 exec, -1
  s_nop 3
  s_lshr_b32 s43, s43, s37
  s_and_b32 s43, s43, 0xff
  s_cmp_lg_u32 s43, 1
  s_cbranch_scc1 L_end
L_combine:
  global_load_dwordx4 v[80:83], v1, s[72:73] sc1
  global_load_dwordx2 v[86:87], v1, s[72:73] offset:1024 sc1
  v_mov_b32 v76, v4
  v_mov_b32 v77, v5
  v_mov_b32 v78, v6
  v_mov_b32 v79, v7
  v_mov_b32 v84, v8
  v_mov_b32 v85, v9
  s_lshl_b32 s36, s22, 9
  s_add_u32 s16, s16, s36
  s_addc_u32 s17, s17, 0
  v_lshrrev_b32 v2, 1, v1
  s_waitcnt vmcnt(0)
  v_max_f32 v8, v84, v86
  v_sub_f32 v84, v84, v8
  v_sub_f32 v86, v86, v8
  v_exp_f32 v84, v84
  v_exp_f32 v86, v86
  s_nop 0
  v_mul_f32 v85, v84, v85
  v_mul_f32 v87, v86, v87
  v_add_f32 v9, v85, v87
  v_rcp_f32 v9, v9
  v_mul_f32 v76, v84, v76
  v_mul_f32 v80, v86, v80
  v_mul_f32 v77, v84, v77
  v_mul_f32 v81, v86, v81
  v_mul_f32 v78, v84, v78
  v_mul_f32 v82, v86, v82
  v_mul_f32 v79, v84, v79
  v_mul_f32 v83, v86, v83
  v_add_f32 v4, v76, v80
  v_add_f32 v5, v77, v81
  v_add_f32 v6, v78, v82
  v_add_f32 v7, v79, v83
  v_mul_f32 v4, v4, v9
  v_mul_f32 v5, v5, v9
  v_mul_f32 v6, v6, v9
  v_mul_f32 v7, v7, v9
  v_cvt_pk_bf16_f32 v4, v4, v5
  v_cvt_pk_bf16_f32 v5, v6, v7
  global_store_dwordx2 v2, v[4:5], s[16:17]
L_end:
L_exit:
  s_endpgm
.section .rodata,"a"
.p2align 6
.amdhsa_kernel standalone__tree_speculative_verify_tree_attention_over_candidate_token_tree__sampling_kernel
  .amdhsa_next_free_vgpr 108
  .amdhsa_next_free_sgpr 80
  .amdhsa_accum_offset 108
  .amdhsa_group_segment_fixed_size 0
  .amdhsa_kernarg_size 72
  .amdhsa_user_sgpr_count 2
  .amdhsa_user_sgpr_kernarg_segment_ptr 1
  .amdhsa_system_sgpr_workgroup_id_x 1
.end_amdhsa_kernel
```
